```python
import torch

def _softmax(x, axis=-1):
    return torch.softmax(x, dim=axis)
def _gelu(x):
    return torch.nn.functional.gelu(x, approximate="tanh")
def _silu(x):
    return torch.nn.functional.silu(x)
def _sigmoid(x):
    return torch.sigmoid(x)
def _layernorm(x, axis=-1, eps=1e-5):
    m = x.mean(dim=axis, keepdim=True)
    v = x.var(dim=axis, keepdim=True, unbiased=False)
    return (x - m) / torch.sqrt(v + eps)
def _scatter_add(tgt, idx, src, axis=0):
    return tgt.clone().index_add_(axis, idx, src)
def _segment_sum(src, seg, n):
    out = torch.zeros((n,) + src.shape[1:], dtype=src.dtype)
    return out.index_add_(0, seg, src)
def _pad(x, pw):
    flat = tuple(v for pair in reversed(pw) for v in pair)
    return torch.nn.functional.pad(x, flat)

kernel_name = 'standalone__glu_gated_glu__decode'

def setup_inputs():

    _w = (lambda a: (lambda t: t.to(torch.bfloat16) if t.is_floating_point() else t)(torch.as_tensor(a)))
    B, S, D, F = 1, 1, 1024, 3584
    return {
        "x": _w((lambda *s: torch.randn(*s, dtype=torch.bfloat16) * 0.1)(B, S, D)),
        "w_gate": _w((lambda *s: torch.randn(*s, dtype=torch.bfloat16) * 0.1)(D, F)),
        "w_up": _w((lambda *s: torch.randn(*s, dtype=torch.bfloat16) * 0.05)(D, F)),
        "w_down": _w((lambda *s: torch.randn(*s, dtype=torch.bfloat16) * 0.05)(F, D)),
    }

def reference(x, w_gate, w_up, w_down):
    g = torch.einsum("bsd,df->bsf", x, w_gate)
    u = torch.einsum("bsd,df->bsf", x, w_up)
    h = _sigmoid(g) * u
    return torch.einsum("bsf,fd->bsd", h, w_down)
```

```asm
; @launch grid=(256,1,1) block=(768,1,1) lds=2144
.amdgcn_target "amdgcn-amd-amdhsa--gfx950"
.text
.globl standalone__glu_gated_glu__decode_kernel
.p2align 8
.type standalone__glu_gated_glu__decode_kernel,@function
standalone__glu_gated_glu__decode_kernel:
    s_load_dwordx8 s[8:15], s[0:1], 0
    s_getpc_b64 s[32:33]
    v_readfirstlane_b32 s28, v0
    s_load_dwordx2 s[20:21], s[0:1], 48
    s_load_dwordx4 s[16:19], s[0:1], 32
    s_and_b32 s4, s2, 7
    s_lshr_b32 s3, s2, 3
    s_lshr_b32 s28, s28, 6
    v_and_b32 v10, 7, v0
    v_lshlrev_b32 v10, 4, v10
    s_sub_u32 s30, s3, 4
    s_cmp_ge_u32 s30, 28
    s_cbranch_scc1 L_server
    v_bfe_u32 v1, v0, 3, 3
    s_mul_i32 s5, s4, 7
    s_lshr_b32 s30, s30, 2
    s_and_b32 s7, s3, 3
    s_cmp_ge_u32 s28, 8
    s_cbranch_scc1 L_down
    v_lshlrev_b32 v2, 6, v0
    v_min_u32 v2, L_cold - standalone__glu_gated_glu__decode_kernel - 12, v2
    global_load_dword v75, v2, s[32:33]
    s_sub_u32 s29, s28, 1
    s_cselect_b32 s29, s30, s29
    s_cselect_b32 s27, s7, s3
    s_and_b32 s6, s27, 15
    s_movk_i32 s26, 7168
    v_lshl_add_u32 v11, s6, 3, v1
    s_add_u32 s23, s5, s29
    s_lshl_b32 s23, s23, 7
    v_mul_u32_u24 v2, 57344, v11
    v_add3_u32 v2, v2, v10, s23
    v_add_u32 v3, s26, v2
    v_add_u32 v4, s26, v3
    v_add_u32 v5, s26, v4
    v_add_u32 v6, s26, v5
    v_add_u32 v7, s26, v6
    v_add_u32 v8, s26, v7
    v_add_u32 v9, s26, v8
    v_bfi_b32 v11, 1, v0, v11
    v_lshlrev_b32 v11, 4, v11
    s_cmp_ge_u32 s27, 16
    s_waitcnt lgkmcnt(0)
    s_cselect_b64 s[10:11], s[12:13], s[10:11]
    global_load_dwordx4 v[12:15], v11, s[8:9]
    global_load_dwordx4 v[16:19], v2, s[10:11] nt
    global_load_dwordx4 v[20:23], v3, s[10:11] nt
    global_load_dwordx4 v[24:27], v4, s[10:11] nt
    global_load_dwordx4 v[28:31], v5, s[10:11] nt
    global_load_dwordx4 v[32:35], v6, s[10:11] nt
    global_load_dwordx4 v[36:39], v7, s[10:11] nt
    global_load_dwordx4 v[40:43], v8, s[10:11] nt
    global_load_dwordx4 v[44:47], v9, s[10:11] nt
    s_branch L_worker
L_server:
    s_cmp_ge_u32 s3, 4
    s_cbranch_scc1 L_srvx
    s_lshl_b32 s22, s2, 14
    s_lshl_b32 s26, s28, 2
    v_mov_b32 v4, s26
    s_cmp_lt_u32 s28, 7
    s_cbranch_scc1 L_srv2
    s_cmp_ge_u32 s28, 8
    s_cbranch_scc1 L_srvx
    s_lshl_b32 s22, s3, 14
    s_lshl_b32 s23, s28, 7
    s_add_u32 s22, s22, s23
    s_add_u32 s22, s22, 6272
    s_add_u32 s28, s28, s3
    s_lshl_b32 s23, s28, 13
    s_and_b32 s23, s23, 0x2000
    s_or_b32 s22, s22, s23
    s_xor_b32 s23, s22, 0x2000
    s_mov_b32 s40, 0x5a3c96e1
    s_mov_b32 s41, s40
    s_mov_b32 s44, s40
.p2align 5
    s_waitcnt lgkmcnt(0)
    s_load_dword s40, s[20:21], s22
    s_load_dword s41, s[20:21], s23
    s_waitcnt lgkmcnt(1)
    s_cmp_eq_u32 s41, s44
    s_cselect_b32 s26, -1, 1
    s_sub_u32 s27, 0, s26
    s_bitcmp1_b32 s28, 0
    s_cselect_b32 s26, s27, s26
    v_mov_b32 v5, s26
    ds_write_b32 v4, v5 offset:2048
L_srvx:
    s_endpgm
L_srv2:
    s_lshl_b32 s23, s28, 10
    v_lshl_add_u32 v73, v0, 4, s22
    s_add_u32 s23, s23, 589824
    v_add_u32 v72, s23, v73
    v_mov_b32 v64, -1
    v_mov_b32 v65, -1
    v_mov_b32 v66, -1
    v_mov_b32 v67, -1
    s_waitcnt lgkmcnt(0)
    global_store_dwordx4 v72, v[64:67], s[20:21]
    global_store_dwordx4 v72, v[64:67], s[20:21] offset:1024
    s_waitcnt vmcnt(0)
    s_memrealtime s[38:39]
    s_getreg_b32 s29, hwreg(HW_REG_XCC_ID, 0, 3)
    s_lshr_b32 s26, s29, 2
    s_or_b32 s29, s29, 8
    s_lshl_b32 s29, s29, 28
    s_or_b32 s29, s29, s26
    s_cmp_lg_u32 s28, 0
    s_waitcnt lgkmcnt(0)
    v_mov_b32 v5, s38
    ds_write_b32 v4, v5 offset:2048
    v_mov_b32 v6, 0
    ds_write_b32 v6, v6 offset:2116
    s_waitcnt lgkmcnt(0)
    s_barrier
    s_cbranch_scc1 L_noflag
    ds_read_b128 v[12:15], v4 offset:2048
    ds_read_b128 v[16:19], v4 offset:2064
    s_lshl_b32 s22, s4, 2
    s_add_u32 s22, s22, s3
    s_lshl_b32 s22, s22, 2
    v_mov_b32 v4, s22
    s_mov_b64 exec, 1
    s_waitcnt lgkmcnt(0)
    v_sub_u32 v13, v13, v12
    v_sub_u32 v14, v14, v12
    v_sub_u32 v15, v15, v12
    v_sub_u32 v16, v16, v12
    v_sub_u32 v17, v17, v12
    v_sub_u32 v18, v18, v12
    v_max3_i32 v13, v13, v14, v15
    v_max3_i32 v16, v16, v17, v18
    v_cmp_lt_i32 vcc, 0, v19
    v_max3_i32 v13, v13, v16, 0
    v_add_u32 v12, v12, v13
    s_xor_b32 s29, s29, vcc_lo
    v_and_b32 v12, 0x7fffff, v12
    v_lshl_or_b32 v5, v12, 5, s29
    global_store_dword v4, v5, s[18:19] sc1
    s_mov_b64 exec, -1
    s_branch L_noflag
L_worker:
    s_cmp_lg_u32 s28, 0
    s_cbranch_scc1 L_nohc
    v_and_b32 v70, 31, v0
    s_lshl_b32 s22, s2, 8
    s_add_u32 s22, s22, 524288
    v_lshl_add_u32 v70, v70, 2, s22
    v_mov_b32 v72, -1
    global_store_dword v70, v72, s[20:21]
L_nohc:
    s_barrier
    v_and_b32 v2, 2, v0
    v_lshlrev_b32 v2, 3, v2
    s_mov_b32 s24, 0x0c0c0100
    s_mov_b32 s25, 0x0c0c0302
    v_alignbit_b32 v3, s24, s24, v2
    v_alignbit_b32 v4, s25, s25, v2
    v_bfe_u32 v2, v0, 2, 2
    v_cmp_eq_u32 s[32:33], 0, v2
    v_cmp_eq_u32 s[34:35], 1, v2
    v_cmp_eq_u32 s[36:37], 2, v2
    v_cmp_eq_u32 s[38:39], 3, v2
    s_lshl_b32 s22, s4, 14
    s_lshl_b32 s23, s29, 11
    s_add_u32 s22, s22, s23
    s_lshl_b32 s26, s27, 6
    s_add_u32 s22, s22, s26
    s_add_u32 s22, s22, 589824
    v_and_b32 v69, 48, v0
    v_lshlrev_b32 v69, 13, v69
    v_and_b32 v71, 15, v0
    v_lshl_add_u32 v74, v71, 2, v69
    v_add_u32 v69, s22, v74
    v_cndmask_b32 v5, 0, -1, s[32:33]
    v_cndmask_b32 v6, 0, -1, s[34:35]
    v_cndmask_b32 v7, 0, -1, s[36:37]
    v_cndmask_b32 v8, 0, -1, s[38:39]
    v_lshlrev_b32 v70, 2, v0
    v_mov_b32 v72, s22
    s_lshl_b32 s22, s28, 2
    v_mov_b32 v71, s22
    ds_write_b32 v71, v72 offset:2048
    v_mov_b32 v73, 0
    s_waitcnt vmcnt(8)
    v_perm_b32 v68, v12, v12, v3
    v_and_b32 v48, v68, v5
    v_and_b32 v49, v68, v6
    v_and_b32 v50, v68, v7
    v_and_b32 v51, v68, v8
    v_perm_b32 v68, v12, v12, v4
    v_and_b32 v52, v68, v5
    v_and_b32 v53, v68, v6
    v_and_b32 v54, v68, v7
    v_and_b32 v55, v68, v8
    v_perm_b32 v68, v13, v13, v3
    v_and_b32 v56, v68, v5
    v_and_b32 v57, v68, v6
    v_and_b32 v58, v68, v7
    v_and_b32 v59, v68, v8
    v_perm_b32 v68, v13, v13, v4
    v_and_b32 v60, v68, v5
    v_and_b32 v61, v68, v6
    v_and_b32 v62, v68, v7
    v_and_b32 v63, v68, v8
    s_waitcnt vmcnt(6)
    v_mfma_f32_16x16x32_bf16 v[64:67], v[48:51], v[16:19], 0
    v_mfma_f32_16x16x32_bf16 v[64:67], v[52:55], v[20:23], v[64:67]
    v_perm_b32 v68, v14, v14, v3
    v_and_b32 v48, v68, v5
    v_and_b32 v49, v68, v6
    v_and_b32 v50, v68, v7
    v_and_b32 v51, v68, v8
    v_perm_b32 v68, v14, v14, v4
    v_and_b32 v52, v68, v5
    v_and_b32 v53, v68, v6
    v_and_b32 v54, v68, v7
    v_and_b32 v55, v68, v8
    s_waitcnt vmcnt(4)
    v_mfma_f32_16x16x32_bf16 v[64:67], v[56:59], v[24:27], v[64:67]
    v_mfma_f32_16x16x32_bf16 v[64:67], v[60:63], v[28:31], v[64:67]
    v_perm_b32 v68, v15, v15, v3
    v_and_b32 v56, v68, v5
    v_and_b32 v57, v68, v6
    v_and_b32 v58, v68, v7
    v_and_b32 v59, v68, v8
    v_perm_b32 v68, v15, v15, v4
    v_and_b32 v60, v68, v5
    v_and_b32 v61, v68, v6
    v_and_b32 v62, v68, v7
    v_and_b32 v63, v68, v8
    s_waitcnt vmcnt(2)
    s_memrealtime s[34:35]
    v_mov_b32 v72, 1
    v_mfma_f32_16x16x32_bf16 v[64:67], v[48:51], v[32:35], v[64:67]
    v_mfma_f32_16x16x32_bf16 v[64:67], v[52:55], v[36:39], v[64:67]
    s_waitcnt vmcnt(1)
    v_mfma_f32_16x16x32_bf16 v[64:67], v[56:59], v[40:43], v[64:67]
    s_waitcnt vmcnt(0)
    v_mfma_f32_16x16x32_bf16 v[64:67], v[60:63], v[44:47], v[64:67]
    s_waitcnt lgkmcnt(0)
    v_mov_b32 v2, s34
    s_cmp_lg_u32 s28, 0
    s_setprio 2
    s_mov_b64 exec, 1
    ds_add_u32 v73, v72 offset:2116
    s_mov_b64 exec, -1
    s_nop 0
    v_add_f32_dpp v64, v65, v64 row_ror:8 row_mask:0xf bank_mask:0x3
    v_add_f32_dpp v64, v66, v67 row_ror:8 row_mask:0xf bank_mask:0xc
    global_store_dword v69, v64, s[20:21]
    ds_write_b32 v70, v64 offset:0
    ds_write_b32 v71, v2 offset:2080
    s_mov_b64 exec, 1
    ds_add_u32 v73, v72 offset:2128
    s_cbranch_scc1 L_end
    s_setprio 0
    s_mov_b64 exec, -1
L_wrec:
    s_sleep 2
    ds_read_b32 v5, v73 offset:2128
    s_waitcnt lgkmcnt(0)
    v_cmp_gt_u32 vcc, 8, v5
    s_cbranch_vccnz L_wrec
    s_lshl_b32 s30, s4, 4
    s_mov_b32 s31, 0
    s_sleep 6
    s_load_dwordx4 s[24:27], s[18:19], s30
    v_lshrrev_b32 v3, 2, v10
    ds_read_b32 v5, v3 offset:2080
    s_getreg_b32 s29, hwreg(HW_REG_XCC_ID, 0, 3)
    s_or_b32 s29, s29, 8
    s_load_dwordx16 s[32:47], s[18:19], 0
    s_load_dwordx16 s[48:63], s[18:19], 64
    s_waitcnt lgkmcnt(0)
    s_lshr_b32 s30, s32, 28
    s_and_b64 s[22:23], s[32:33], s[34:35]
    s_and_b64 s[22:23], s[22:23], s[36:37]
    s_and_b64 s[22:23], s[22:23], s[38:39]
    s_and_b64 s[22:23], s[22:23], s[40:41]
    s_and_b64 s[22:23], s[22:23], s[42:43]
    s_and_b64 s[22:23], s[22:23], s[44:45]
    s_and_b64 s[22:23], s[22:23], s[46:47]
    s_and_b64 s[22:23], s[22:23], s[48:49]
    s_and_b64 s[22:23], s[22:23], s[50:51]
    s_and_b64 s[22:23], s[22:23], s[52:53]
    s_and_b64 s[22:23], s[22:23], s[54:55]
    s_and_b64 s[22:23], s[22:23], s[56:57]
    s_and_b64 s[22:23], s[22:23], s[58:59]
    s_and_b64 s[22:23], s[22:23], s[60:61]
    s_and_b64 s[22:23], s[22:23], s[62:63]
    s_add_u32 s32, s32, s34
    s_add_u32 s33, s33, s35
    s_add_u32 s32, s32, s36
    s_add_u32 s33, s33, s37
    s_add_u32 s32, s32, s38
    s_add_u32 s33, s33, s39
    s_add_u32 s32, s32, s40
    s_add_u32 s33, s33, s41
    s_add_u32 s32, s32, s42
    s_add_u32 s33, s33, s43
    s_add_u32 s32, s32, s44
    s_add_u32 s33, s33, s45
    s_add_u32 s32, s32, s46
    s_add_u32 s33, s33, s47
    s_add_u32 s32, s32, s48
    s_add_u32 s33, s33, s49
    s_add_u32 s32, s32, s50
    s_add_u32 s33, s33, s51
    s_add_u32 s32, s32, s52
    s_add_u32 s33, s33, s53
    s_add_u32 s32, s32, s54
    s_add_u32 s33, s33, s55
    s_add_u32 s32, s32, s56
    s_add_u32 s33, s33, s57
    s_add_u32 s32, s32, s58
    s_add_u32 s33, s33, s59
    s_add_u32 s32, s32, s60
    s_add_u32 s33, s33, s61
    s_add_u32 s32, s32, s62
    s_add_u32 s33, s33, s63
    s_and_b32 s22, s22, s23
    s_cmp_ge_i32 s22, 0
    s_cbranch_scc1 L_wvec
L_wok:
    s_and_b32 s22, s32, 31
    s_and_b32 s23, s33, 31
    s_add_u32 s22, s22, s23
    s_cmp_gt_u32 s22, 16
    s_cselect_b32 s22, 4, 0
    s_xor_b32 s30, s30, s22
    s_mul_i32 s32, s32, 0x9e3779b1
    s_add_u32 s33, s33, s32
    s_mul_i32 s33, s33, 0x85ebca77
    s_lshr_b32 s22, s33, 15
    s_xor_b32 s32, s32, s22
    s_lshr_b32 s33, s33, 11
    s_lshl_b32 s22, s30, 28
    s_or_b32 s33, s33, s22
    v_mov_b32 v6, s32
    v_mov_b32 v7, s33
    ds_write_b64 v73, v[6:7] offset:2120
    v_mov_b32 v4, s24
    s_mov_b64 exec, 0xff00
    v_mov_b32 v4, s25
    s_mov_b64 exec, 0xff0000
    v_mov_b32 v4, s26
    s_mov_b32 exec_lo, 0xff000000
    v_mov_b32 v4, s27
    s_mov_b32 exec_lo, -1
    v_lshlrev_b32 v5, 5, v5
    v_sub_u32 v5, v5, v4
    v_lshlrev_b32 v5, 4, v5
    v_lshrrev_b32 v4, 28, v4
    v_cmp_gt_i32 vcc, 0x400, v5
    v_cmp_ne_u32 s[24:25], s29, v4
    s_nop 3
    s_or_b64 s[24:25], s[24:25], vcc
    s_cbranch_scc1 L_repair
    s_endpgm
L_down:
    s_and_b32 s28, s28, 3
    s_add_u32 s6, s30, s5
    s_lshl_b32 s7, s7, 2
    s_add_u32 s7, s7, s28
    s_lshl_b32 s22, s6, 17
    s_lshl_b32 s26, s7, 7
    s_add_u32 s22, s22, s26
    s_add_u32 s22, s22, 4096
    v_lshlrev_b32 v2, 14, v1
    v_add3_u32 v2, v2, v10, s22
    v_add_u32 v3, 0x2000, v2
    s_and_b32 s22, s7, 8
    s_add_u32 s22, s22, s7
    s_lshl_b32 s22, s22, 14
    s_lshl_b32 s26, s6, 7
    s_add_u32 s22, s22, s26
    v_and_b32 v5, 8, v0
    v_lshlrev_b32 v5, 14, v5
    v_add3_u32 v5, v5, v10, s22
    s_lshl_b32 s22, s2, 8
    s_add_u32 s22, s22, 524288
    v_bfi_b32 v4, 1, v0, v1
    v_lshl_add_u32 v4, v4, 4, s22
    v_mov_b32 v6, 0
    v_mov_b32 v7, 0
    ds_write_b64 v6, v[6:7] offset:2112
    ds_write_b64 v6, v[6:7] offset:2120
    ds_write_b32 v6, v6 offset:2128
    s_mov_b32 s24, 0x05040100
    s_mov_b32 s25, 0x07060302
    s_mov_b32 s31, 0
    s_waitcnt lgkmcnt(0)
    s_barrier
L_gate:
    s_sleep 1
    ds_read_b32 v7, v6 offset:2116
    s_waitcnt lgkmcnt(0)
    v_cmp_gt_u32 vcc, 3, v7
    s_cbranch_vccnz L_gate
    global_load_dwordx4 v[16:19], v2, s[14:15] offset:-4096 nt
    global_load_dwordx4 v[20:23], v2, s[14:15] offset:-2048 nt
L_gate2:
    ds_read_b32 v7, v6 offset:2116
    s_waitcnt lgkmcnt(0)
    v_cmp_gt_u32 vcc, 8, v7
    s_cbranch_vccnz L_gate2
    global_load_dwordx4 v[24:27], v2, s[14:15] offset:0 nt
    global_load_dwordx4 v[28:31], v2, s[14:15] offset:2048 nt
    global_load_dwordx4 v[32:35], v3, s[14:15] offset:-4096 nt
    global_load_dwordx4 v[36:39], v3, s[14:15] offset:-2048 nt
    global_load_dwordx4 v[40:43], v3, s[14:15] offset:0 nt
    global_load_dwordx4 v[44:47], v3, s[14:15] offset:2048 nt
    global_load_dwordx4 v[12:15], v4, s[20:21] sc1
    s_waitcnt vmcnt(7)
L_dnon:
    ds_read_b64 v[2:3], v6 offset:2120
    s_waitcnt lgkmcnt(0)
    v_cmp_le_i32 vcc, 0, v3
    s_cbranch_vccnz L_dnon
    v_lshrrev_b32 v7, 28, v3
    v_lshrrev_b32 v8, 14, v5
    v_add_u32 v7, v7, v8
    v_and_b32 v7, 4, v7
    v_lshl_add_u32 v5, v7, 11, v5
    v_and_b32 v7, 3, v0
    v_mul_u32_u24 v7, 12, v7
    v_lshrrev_b64 v[2:3], v7, v[2:3]
    v_bfe_u32 v8, v2, 0, 3
    v_bfe_u32 v9, v2, 3, 3
    v_bfe_u32 v10, v2, 6, 3
    v_bfe_u32 v11, v2, 9, 3
    v_perm_b32 v48, v20, v16, s24
    v_perm_b32 v52, v20, v16, s25
    v_perm_b32 v56, v21, v17, s24
    v_perm_b32 v60, v21, v17, s25
    v_perm_b32 v64, v22, v18, s24
    v_perm_b32 v68, v22, v18, s25
    v_perm_b32 v72, v23, v19, s24
    v_perm_b32 v76, v23, v19, s25
    s_waitcnt vmcnt(5)
    v_perm_b32 v49, v28, v24, s24
    v_perm_b32 v53, v28, v24, s25
    v_perm_b32 v57, v29, v25, s24
    v_perm_b32 v61, v29, v25, s25
    v_perm_b32 v65, v30, v26, s24
    v_perm_b32 v69, v30, v26, s25
    v_perm_b32 v73, v31, v27, s24
    v_perm_b32 v77, v31, v27, s25
    s_waitcnt vmcnt(3)
    v_perm_b32 v50, v36, v32, s24
    v_perm_b32 v54, v36, v32, s25
    v_perm_b32 v58, v37, v33, s24
    v_perm_b32 v62, v37, v33, s25
    v_perm_b32 v66, v38, v34, s24
    v_perm_b32 v70, v38, v34, s25
    v_perm_b32 v74, v39, v35, s24
    v_perm_b32 v78, v39, v35, s25
    s_waitcnt vmcnt(1)
    v_perm_b32 v51, v44, v40, s24
    v_perm_b32 v67, v46, v42, s24
    v_perm_b32 v55, v44, v40, s25
    v_perm_b32 v71, v46, v42, s25
    s_waitcnt vmcnt(0)
    v_mfma_f32_16x16x32_bf16 v[16:19], v[12:15], v[48:51], 0
    v_perm_b32 v59, v45, v41, s24
    v_perm_b32 v63, v45, v41, s25
    v_mfma_f32_16x16x32_bf16 v[32:35], v[12:15], v[64:67], 0
    v_perm_b32 v75, v47, v43, s24
    v_perm_b32 v79, v47, v43, s25
    v_mfma_f32_16x16x32_bf16 v[20:23], v[12:15], v[52:55], 0
    v_max3_u32 v7, v12, v13, v14
    v_max_u32 v7, v7, v15
    v_mfma_f32_16x16x32_bf16 v[36:39], v[12:15], v[68:71], 0
    v_cmp_eq_u32 vcc, -1, v7
    s_cbranch_vccnz L_hpoll
L_hrest:
    v_mfma_f32_16x16x32_bf16 v[24:27], v[12:15], v[56:59], 0
    v_add_f32_dpp v18, v17, v16 row_ror:8 row_mask:0xf bank_mask:0x3
    v_mfma_f32_16x16x32_bf16 v[40:43], v[12:15], v[72:75], 0
    v_add_f32_dpp v18, v32, v33 row_ror:8 row_mask:0xf bank_mask:0xc
    v_mfma_f32_16x16x32_bf16 v[28:31], v[12:15], v[60:63], 0
    v_add_f32_dpp v22, v21, v20 row_ror:8 row_mask:0xf bank_mask:0x3
    v_mfma_f32_16x16x32_bf16 v[44:47], v[12:15], v[76:79], 0
    v_add_f32_dpp v22, v36, v37 row_ror:8 row_mask:0xf bank_mask:0xc
    v_bfi_b32 v8, 7, v8, v18
    v_bfi_b32 v9, 7, v9, v22
    v_add_f32_dpp v26, v25, v24 row_ror:8 row_mask:0xf bank_mask:0x3
    s_mov_b64 exec, 0xffff
    v_add_f32_dpp v26, v40, v41 row_ror:8 row_mask:0xf bank_mask:0xc
    v_add_f32_dpp v30, v29, v28 row_ror:8 row_mask:0xf bank_mask:0x3
    v_bfi_b32 v10, 7, v10, v26
    v_add_f32_dpp v30, v44, v45 row_ror:8 row_mask:0xf bank_mask:0xc
    v_bfi_b32 v11, 7, v11, v30
    global_store_dwordx4 v5, v[8:11], s[20:21] sc1
    s_endpgm
L_hpoll:
    global_load_dwordx4 v[12:15], v4, s[20:21] sc1
    s_add_u32 s31, s31, 1
    s_cmp_ge_u32 s31, 40
    s_waitcnt vmcnt(0)
    v_max3_u32 v7, v12, v13, v14
    v_max_u32 v7, v7, v15
    v_cmp_eq_u32 vcc, -1, v7
    s_cbranch_scc1 L_hfar
    s_cbranch_vccnz L_hpoll
L_hgot:
    v_mfma_f32_16x16x32_bf16 v[16:19], v[12:15], v[48:51], 0
    v_mfma_f32_16x16x32_bf16 v[32:35], v[12:15], v[64:67], 0
    v_mfma_f32_16x16x32_bf16 v[20:23], v[12:15], v[52:55], 0
    v_mfma_f32_16x16x32_bf16 v[36:39], v[12:15], v[68:71], 0
    s_nop 3
    s_branch L_hrest
L_noflag:
    v_add_u32 v31, 0x400, v72
    v_mov_b32 v30, v72
    v_and_b32 v2, 3, v0
    s_lshl_b32 s22, s4, 8
    s_lshl_b32 s26, s28, 13
    s_add_u32 s22, s22, s26
    s_lshl_b32 s26, s3, 2
    s_add_u32 s22, s22, s26
    s_add_u32 s22, s22, 532480
    v_and_b32 v6, 12, v0
    v_lshlrev_b32 v6, 9, v6
    v_and_b32 v3, 1, v0
    v_lshl_add_u32 v6, v3, 6, v6
    v_and_b32 v3, 48, v0
    v_add3_u32 v6, v6, v3, s22
    v_lshlrev_b32 v8, 3, v10
    v_lshl_add_u32 v8, v3, 1, v8
    s_lshl_b32 s22, s28, 2
    v_add_u32 v8, s22, v8
    v_and_b32 v9, 31, v0
    v_lshlrev_b32 v9, 5, v9
    v_and_b32 v11, 28, v0
    v_lshlrev_b32 v11, 2, v11
    v_lshl_add_u32 v11, v2, 1, v11
    s_and_b32 s22, s2, 16
    s_lshl_b32 s22, s22, 6
    s_lshl_b32 s26, s4, 7
    s_add_u32 s22, s22, s26
    s_and_b32 s26, s2, 8
    s_add_u32 s22, s22, s26
    v_add_u32 v11, s22, v11
    s_mov_b32 s27, 0xbfb8aa3b
    s_mov_b32 s31, 0
    s_mov_b32 s36, 0
    s_mov_b32 s34, 0x33333333
    s_mov_b32 s35, 0x33333333
    s_sleep 40
L_spoll:
    global_load_dwordx4 v[20:23], v30, s[20:21] sc1
    global_load_dwordx4 v[24:27], v31, s[20:21] sc1
    s_add_u32 s31, s31, 1
    s_and_b32 s22, s31, 63
    s_waitcnt vmcnt(1)
    v_max3_u32 v28, v20, v21, v22
    s_waitcnt vmcnt(0)
    v_max3_u32 v29, v23, v24, v25
    v_max3_u32 v28, v28, v26, v27
    v_max_u32 v28, v28, v29
    v_cmp_eq_u32 vcc, -1, v28
    s_cbranch_scc0 L_sredir
    s_cbranch_vccnz L_spoll
L_sgot:
    v_permlane32_swap_b32 v20, v22
    v_permlane32_swap_b32 v21, v23
    v_permlane32_swap_b32 v24, v26
    v_permlane32_swap_b32 v25, v27
    v_pk_add_f32 v[20:21], v[20:21], v[22:23]
    v_pk_add_f32 v[24:25], v[24:25], v[26:27]
    s_nop 0
    v_permlane16_swap_b32 v20, v21
    v_permlane16_swap_b32 v24, v25
    v_add_f32 v20, v20, v21
    v_add_f32 v24, v24, v25
    s_nop 0
    v_add_f32_dpp v20, v20, v20 row_ror:8 row_mask:0xf bank_mask:0xf
    v_add_f32_dpp v24, v24, v24 row_ror:8 row_mask:0xf bank_mask:0xf
    s_nop 0
    v_add_f32_dpp v20, v20, v20 row_ror:4 row_mask:0xf bank_mask:0xf
    v_add_f32_dpp v24, v24, v24 row_ror:4 row_mask:0xf bank_mask:0xf
    v_cvt_pk_bf16_f32 v28, v20, v24
    v_lshlrev_b32 v29, 16, v28
    v_mul_f32 v29, s27, v29
    v_exp_f32 v29, v29
    v_and_b32 v28, 0xffff0000, v28
    v_add_f32 v29, 1.0, v29
    v_rcp_f32 v29, v29
    s_cmp_lg_u32 s36, 0
    v_cvt_pk_bf16_f32 v29, v29, v29
    v_lshlrev_b32 v29, 16, v29
    v_mul_f32 v29, v29, v28
    s_nop 1
    v_mov_b32_dpp v28, v29 quad_perm:[2,3,0,1] row_mask:0xf bank_mask:0xf
    s_mov_b64 exec, s[34:35]
    v_cvt_pk_bf16_f32 v29, v29, v28
    global_store_dword v6, v29, s[20:21]
    s_cbranch_scc1 L_hsendfar
L_hsent:
    s_mov_b64 exec, -1
    s_load_dwordx16 s[32:47], s[18:19], 0
    s_load_dwordx16 s[48:63], s[18:19], 64
    s_waitcnt lgkmcnt(0)
    s_lshr_b32 s30, s32, 28
    s_and_b64 s[22:23], s[32:33], s[34:35]
    s_and_b64 s[22:23], s[22:23], s[36:37]
    s_and_b64 s[22:23], s[22:23], s[38:39]
    s_and_b64 s[22:23], s[22:23], s[40:41]
    s_and_b64 s[22:23], s[22:23], s[42:43]
    s_and_b64 s[22:23], s[22:23], s[44:45]
    s_and_b64 s[22:23], s[22:23], s[46:47]
    s_and_b64 s[22:23], s[22:23], s[48:49]
    s_and_b64 s[22:23], s[22:23], s[50:51]
    s_and_b64 s[22:23], s[22:23], s[52:53]
    s_and_b64 s[22:23], s[22:23], s[54:55]
    s_and_b64 s[22:23], s[22:23], s[56:57]
    s_and_b64 s[22:23], s[22:23], s[58:59]
    s_and_b64 s[22:23], s[22:23], s[60:61]
    s_and_b64 s[22:23], s[22:23], s[62:63]
    s_add_u32 s32, s32, s34
    s_add_u32 s33, s33, s35
    s_add_u32 s32, s32, s36
    s_add_u32 s33, s33, s37
    s_add_u32 s32, s32, s38
    s_add_u32 s33, s33, s39
    s_add_u32 s32, s32, s40
    s_add_u32 s33, s33, s41
    s_add_u32 s32, s32, s42
    s_add_u32 s33, s33, s43
    s_add_u32 s32, s32, s44
    s_add_u32 s33, s33, s45
    s_add_u32 s32, s32, s46
    s_add_u32 s33, s33, s47
    s_add_u32 s32, s32, s48
    s_add_u32 s33, s33, s49
    s_add_u32 s32, s32, s50
    s_add_u32 s33, s33, s51
    s_add_u32 s32, s32, s52
    s_add_u32 s33, s33, s53
    s_add_u32 s32, s32, s54
    s_add_u32 s33, s33, s55
    s_add_u32 s32, s32, s56
    s_add_u32 s33, s33, s57
    s_add_u32 s32, s32, s58
    s_add_u32 s33, s33, s59
    s_add_u32 s32, s32, s60
    s_add_u32 s33, s33, s61
    s_add_u32 s32, s32, s62
    s_add_u32 s33, s33, s63
    s_and_b32 s22, s22, s23
    s_cmp_ge_i32 s22, 0
    s_cbranch_scc1 L_svec
L_sok:
    s_and_b32 s22, s32, 31
    s_and_b32 s23, s33, 31
    s_add_u32 s22, s22, s23
    s_cmp_gt_u32 s22, 16
    s_cselect_b32 s22, 4, 0
    s_xor_b32 s30, s30, s22
    s_mul_i32 s32, s32, 0x9e3779b1
    s_add_u32 s33, s33, s32
    s_mul_i32 s33, s33, 0x85ebca77
    s_lshr_b32 s22, s33, 15
    s_xor_b32 s32, s32, s22
    s_lshr_b32 s33, s33, 11
    s_lshl_b32 s22, s30, 28
    s_or_b32 s33, s33, s22
    v_mov_b32 v4, s32
    v_mov_b32 v5, s33
    s_add_u32 s22, s30, s2
    s_and_b32 s22, s22, 4
    s_lshl_b32 s22, s22, 11
    v_add_u32 v73, s22, v73
    v_and_b32 v3, 3, v0
    v_mul_u32_u24 v3, 12, v3
    v_lshrrev_b64 v[4:5], v3, v[4:5]
    v_bfe_u32 v76, v4, 0, 3
    v_bfe_u32 v77, v4, 3, 3
    v_bfe_u32 v78, v4, 6, 3
    v_bfe_u32 v79, v4, 9, 3
    v_mov_b32 v4, 0
    v_mov_b32 v5, 1
    s_sleep 24
L_cpoll:
    global_load_dwordx4 v[20:23], v73, s[20:21] sc1
    s_add_u32 s31, s31, 1
    s_cmp_gt_u32 s31, 120000
    s_waitcnt vmcnt(0)
    v_xor_b32 v20, v20, v76
    v_xor_b32 v21, v21, v77
    v_xor_b32 v22, v22, v78
    v_xor_b32 v23, v23, v79
    v_or3_b32 v3, v20, v21, v22
    v_bitop3_b32 v3, v3, v23, 7 bitop3:0xa8
    v_permlane32_swap_b32 v20, v22
    v_cmp_ne_u32 vcc, 0, v3
    v_permlane32_swap_b32 v21, v23
    s_cbranch_scc1 L_cgot
    s_cbranch_vccnz L_cpoll
L_cgot:
    v_pk_add_f32 v[20:21], v[20:21], v[22:23]
    s_cmp_lg_u32 s28, 0
    s_nop 0
    v_permlane16_swap_b32 v20, v21
    v_add_f32 v20, v20, v21
    s_nop 1
    v_add_f32_dpp v20, v20, v20 row_ror:8 row_mask:0xf bank_mask:0xf
    ds_write_b32 v8, v20
    s_mov_b64 exec, 1
    ds_add_rtn_u32 v3, v4, v5 offset:2116
    s_mov_b32 exec_lo, -1
    ds_read_b128 v[20:23], v9
    ds_read_b128 v[24:27], v9 offset:16
    s_waitcnt lgkmcnt(2)
    v_readfirstlane_b32 s22, v3
    s_waitcnt lgkmcnt(1)
    v_pk_add_f32 v[20:21], v[20:21], v[22:23]
    s_cmp_lg_u32 s22, 6
    s_cbranch_scc1 L_end
    s_waitcnt lgkmcnt(0)
    v_pk_add_f32 v[20:21], v[20:21], v[24:25]
    v_add_f32 v20, v20, v26
    v_add_f32 v20, v20, v21
    v_cvt_pk_bf16_f32 v20, v20, v20
    global_store_short v11, v20, s[16:17]
L_end:
    s_endpgm
L_wvec:
    s_mov_b64 exec, -1
    v_and_b32 v8, 31, v0
    v_lshlrev_b32 v8, 2, v8
L_wvec2:
    s_sleep 4
    global_load_dword v9, v8, s[18:19] sc1
    s_add_u32 s31, s31, 1
    s_cmp_gt_u32 s31, 40000
    s_waitcnt vmcnt(0)
    v_cmp_le_i32 vcc, 0, v9
    s_cbranch_scc1 L_wvec3
    s_cbranch_vccnz L_wvec2
L_wvec3:
    v_readlane_b32 s30, v9, 0
    s_mov_b64 s[32:33], 0
    s_mov_b32 s23, 0
    s_nop 1
    s_lshr_b32 s30, s30, 28
    s_or_b32 s30, s30, 8
L_wvec4:
    v_readlane_b32 s22, v9, s23
    s_add_u32 s23, s23, 1
    v_readlane_b32 s34, v9, s23
    s_add_u32 s23, s23, 1
    s_nop 2
    s_add_u32 s32, s32, s22
    s_add_u32 s33, s33, s34
    s_cmp_lt_u32 s23, 32
    s_cbranch_scc1 L_wvec4
    s_lshl_b32 s22, s4, 2
    v_readlane_b32 s24, v9, s22
    s_add_u32 s22, s22, 1
    v_readlane_b32 s25, v9, s22
    s_add_u32 s22, s22, 1
    v_readlane_b32 s26, v9, s22
    s_add_u32 s22, s22, 1
    v_readlane_b32 s27, v9, s22
    s_add_u32 s22, s22, 1
    s_branch L_wok
L_cold:
L_repair:
    s_mov_b64 exec, -1
    v_mov_b32 v6, 0
    v_mov_b32 v7, 1
    v_and_b32 v9, 63, v0
    v_lshlrev_b32 v9, 2, v9
    ds_read_b32 v12, v9 offset:0
    ds_read_b32 v13, v9 offset:256
    ds_read_b32 v14, v9 offset:512
    ds_read_b32 v15, v9 offset:768
    ds_read_b32 v16, v9 offset:1024
    ds_read_b32 v17, v9 offset:1280
    ds_read_b32 v18, v9 offset:1536
    ds_read_b32 v19, v9 offset:1792
    ds_read_b128 v[20:23], v6 offset:2048
    ds_read_b128 v[24:27], v6 offset:2064
    v_add_u32 v74, 524288, v74
    s_waitcnt lgkmcnt(0)
    v_add_u32 v20, v20, v74
    global_store_dword v20, v12, s[20:21] sc1
    v_add_u32 v21, v21, v74
    global_store_dword v21, v13, s[20:21] sc1
    v_add_u32 v22, v22, v74
    global_store_dword v22, v14, s[20:21] sc1
    v_add_u32 v23, v23, v74
    global_store_dword v23, v15, s[20:21] sc1
    v_add_u32 v24, v24, v74
    global_store_dword v24, v16, s[20:21] sc1
    v_add_u32 v25, v25, v74
    global_store_dword v25, v17, s[20:21] sc1
    v_add_u32 v26, v26, v74
    global_store_dword v26, v18, s[20:21] sc1
    v_add_u32 v27, v27, v74
    global_store_dword v27, v19, s[20:21] sc1
    s_lshl_b32 s22, s2, 8
    s_add_u32 s22, s22, 524416
    v_and_b32 v9, 0x7c, v9
    v_add_u32 v9, s22, v9
    v_mov_b32 v8, -1
    global_store_dword v9, v8, s[20:21] sc1
    s_lshl_b32 s22, s4, 2
    v_mov_b32 v8, s22
    s_lshl_b32 s22, 1, s3
    v_mov_b32 v9, s22
    s_mov_b64 exec, 1
    s_waitcnt vmcnt(0)
    ds_write_b32 v6, v7 offset:2112
    global_atomic_or v8, v9, s[18:19] offset:128 sc1
    s_branch L_end
L_svec:
    s_mov_b64 exec, -1
    v_and_b32 v4, 31, v0
    v_lshlrev_b32 v4, 2, v4
L_svec2:
    s_sleep 4
    global_load_dword v5, v4, s[18:19] sc1
    s_add_u32 s31, s31, 1
    s_cmp_gt_u32 s31, 40000
    s_waitcnt vmcnt(0)
    v_cmp_le_i32 vcc, 0, v5
    s_cbranch_scc1 L_svec3
    s_cbranch_vccnz L_svec2
L_svec3:
    v_readlane_b32 s30, v5, 0
    s_mov_b64 s[32:33], 0
    s_mov_b32 s23, 0
    s_nop 1
    s_lshr_b32 s30, s30, 28
    s_or_b32 s30, s30, 8
L_svec4:
    v_readlane_b32 s22, v5, s23
    s_add_u32 s23, s23, 1
    v_readlane_b32 s34, v5, s23
    s_add_u32 s23, s23, 1
    s_nop 2
    s_add_u32 s32, s32, s22
    s_add_u32 s33, s33, s34
    s_cmp_lt_u32 s23, 32
    s_cbranch_scc1 L_svec4
    s_branch L_sok
L_sredir:
    s_cbranch_vccz L_sgot
    s_cmp_gt_u32 s31, 40000
    s_cbranch_scc1 L_sgot
    s_lshl_b32 s22, s4, 2
    v_mov_b32 v28, s22
    global_load_dword v28, v28, s[18:19] offset:128 sc1
    v_bfe_u32 v29, v0, 2, 4
    s_lshl_b32 s22, s28, 2
    s_add_u32 s22, s22, 4
    s_waitcnt vmcnt(0)
    v_readfirstlane_b32 s36, v28
    s_nop 3
    s_lshr_b32 s22, s36, s22
    s_and_b32 s22, s22, 15
    s_or_b32 s36, s36, s22
    v_lshrrev_b32 v28, v29, s36
    v_and_b32 v29, 1, v28
    v_lshlrev_b32 v29, 19, v29
    v_add_u32 v30, v29, v72
    v_bfe_u32 v29, v28, 16, 1
    v_lshlrev_b32 v29, 19, v29
    v_add_u32 v31, v29, v72
    v_add_u32 v31, 0x400, v31
    s_branch L_spoll
L_hfar:
    s_cbranch_vccz L_hgot
    s_cmp_gt_u32 s31, 80000
    s_cbranch_scc1 L_hgot
    ds_read_b32 v7, v6 offset:2112
    s_waitcnt lgkmcnt(0)
    v_cmp_eq_u32 vcc, 0, v7
    s_cbranch_vccnz L_hpoll
    global_load_dwordx4 v[16:19], v4, s[20:21] offset:128 sc1
    s_waitcnt vmcnt(0)
    v_and_b32 v12, v12, v16
    v_and_b32 v13, v13, v17
    v_and_b32 v14, v14, v18
    v_and_b32 v15, v15, v19
    v_max3_u32 v7, v12, v13, v14
    v_max_u32 v7, v7, v15
    v_cmp_eq_u32 vcc, -1, v7
    s_cbranch_vccnz L_hpoll
    s_branch L_hgot
L_hsendfar:
    v_bfe_u32 v28, v0, 2, 2
    v_lshrrev_b32 v28, v28, s36
    v_and_b32 v28, 1, v28
    v_cmp_eq_u32 vcc, 1, v28
    s_and_b64 exec, exec, vcc
    s_cbranch_execz L_hsent
    global_store_dword v6, v29, s[20:21] offset:128 sc1
    s_branch L_hsent
.section .rodata,"a"
.p2align 6
.amdhsa_kernel standalone__glu_gated_glu__decode_kernel
  .amdhsa_next_free_vgpr 80
  .amdhsa_next_free_sgpr 64
  .amdhsa_accum_offset 80
  .amdhsa_group_segment_fixed_size 0
  .amdhsa_kernarg_size 56
  .amdhsa_user_sgpr_count 2
  .amdhsa_user_sgpr_kernarg_segment_ptr 1
  .amdhsa_system_sgpr_workgroup_id_x 1
  .amdhsa_float_denorm_mode_32 3
.end_amdhsa_kernel
```
